```python
import torch

def _softmax(x, axis=-1):
    return torch.softmax(x, dim=axis)
def _gelu(x):
    return torch.nn.functional.gelu(x, approximate="tanh")
def _silu(x):
    return torch.nn.functional.silu(x)
def _sigmoid(x):
    return torch.sigmoid(x)
def _layernorm(x, axis=-1, eps=1e-5):
    m = x.mean(dim=axis, keepdim=True)
    v = x.var(dim=axis, keepdim=True, unbiased=False)
    return (x - m) / torch.sqrt(v + eps)
def _scatter_add(tgt, idx, src, axis=0):
    return tgt.clone().index_add_(axis, idx, src)
def _segment_sum(src, seg, n):
    out = torch.zeros((n,) + src.shape[1:], dtype=src.dtype)
    return out.index_add_(0, seg, src)
def _pad(x, pw):
    flat = tuple(v for pair in reversed(pw) for v in pair)
    return torch.nn.functional.pad(x, flat)

kernel_name = 'standalone__instancenorm__sampling'

def setup_inputs():

    _w = (lambda a: (lambda t: t.to(torch.bfloat16) if t.is_floating_point() else t)(torch.as_tensor(a)))
    B, C, H, W = 32, 512, 32, 32
    return {
        "x": _w(abs((lambda *s: torch.randn(*s, dtype=torch.bfloat16) * 0.05)(B, C, H, W))),
        "g": _w((lambda *s: torch.randn(*s, dtype=torch.bfloat16) * 0.05)(C) + 1.0),
        "b": _w((lambda *s: torch.randn(*s, dtype=torch.bfloat16) * 0.4)(C)),
    }

def reference(x, g, b):
    mu = x.mean(axis=(-2, -1), keepdims=True)
    var = ((x - mu) ** 2).mean(axis=(-2, -1), keepdims=True)
    xhat = (x - mu) / torch.sqrt(var + 1e-5)
    return xhat * g.reshape(1, -1, 1, 1) + b.reshape(1, -1, 1, 1)
```

```asm
; @launch grid=(256,1,1) block=(512,1,1) lds=0
.amdgcn_target "amdgcn-amd-amdhsa--gfx950"
.text
.globl standalone__instancenorm__sampling_kernel
.p2align 12
.p2align 8
.type standalone__instancenorm__sampling_kernel,@function
standalone__instancenorm__sampling_kernel:
    s_load_dwordx2 s[12:13], s[0:1], 0
    s_load_dwordx4 s[4:7], s[0:1], 8
    s_load_dwordx4 s[8:11], s[0:1], 24
    v_readfirstlane_b32 s20, v0
    v_and_b32 v2, 63, v0
    s_cmp_ge_u32 s2, 256
    s_cbranch_scc1 L_done
    v_lshlrev_b32 v2, 4, v2
    s_lshl_b32 s32, s2, 9
    s_add_u32 s32, s32, s20
    s_lshl_b32 s32, s32, 5
    s_add_u32 s33, s32, 4194304
    s_mov_b32 s14, 0x2000000
    s_mov_b32 s15, 0x20000
    s_getreg_b32 s23, hwreg(HW_REG_HW_ID, 0, 16)
    s_lshr_b32 s22, s0, 3
    s_add_u32 s22, s22, s2
    s_lshl_b32 s23, s23, 16
    s_xor_b32 s22, s22, s23
    s_mul_i32 s22, s22, 0x9e3779b1
    s_lshr_b32 s22, s22, 7
    s_and_b32 s22, s22, 0xdfdfc0
    s_lshl_b32 s23, s2, 13
    s_and_b32 s23, s23, 8192
    s_or_b32 s22, s22, s23
    s_bitset1_b32 s22, 24
    s_xor_b32 s23, s22, 8192
    s_mov_b32 s19, -1
    s_lshr_b32 s17, s32, 10
    s_and_b32 s17, s17, 0x3fc
    s_lshl_b32 s27, s20, 2
    s_or_b32 s27, s27, s2
    s_cmp_ge_u32 s27, 8
    s_waitcnt lgkmcnt(0)
    s_cbranch_scc1 L_np
    s_load_dword s18, s[12:13], s22 glc
    s_load_dword s19, s[12:13], s23 glc
L_np:
    buffer_load_dwordx4 v[32:35], v2, s[12:15], s32 offen nt
    buffer_load_dwordx4 v[36:39], v2, s[12:15], s32 offen offset:1024 nt
    s_cbranch_scc0 L_np2
    s_load_dword s40, s[4:5], s17
    s_load_dword s41, s[6:7], s17
L_np2:
    s_cmp_lt_u32 s20, 256
    s_cbranch_scc1 L_pd
    s_setprio 1
L_pd:
    s_mov_b32 s28, s8
    s_mov_b32 s29, s9
    s_mov_b32 s30, 0x2000000
    s_mov_b32 s31, 0x20000
    s_mov_b32 s25, 0x44800000
    s_mov_b32 s26, 0xffff0000
    s_cmp_ge_u32 s27, 8
    s_cbranch_scc1 L_nw
    s_waitcnt lgkmcnt(1)
L_nw:
    v_mov_b32 v4, 0xba800000
    v_mov_b32 v5, 0x3727c5ac
    v_mov_b32 v3, 0
    v_mov_b32 v14, 0x3f80
    v_mov_b32 v15, 0x3f800000
    s_bitcmp0_b32 s20, 6
    s_cselect_b32 s24, 16, 0
    s_getreg_b32 s21, hwreg(HW_REG_XCC_ID, 0, 2)
    s_lshr_b32 s44, s22, 11
    s_and_b32 s44, s44, 4
    s_or_b32 s44, s44, s21
    s_sub_u32 s44, s44, s2
    s_and_b32 s44, s44, 7
    s_or_b32 s44, s44, 8
    s_mov_b32 s45, 0
    s_xor_b32 s46, s44, 4
    s_mov_b32 s47, 0
    s_cmp_ge_u32 s27, 8
    s_cbranch_scc1 L_r0
    s_cmp_eq_u32 s19, -1
    s_cbranch_scc0 L_nc
    s_atomic_cmpswap s[44:45], s[10:11], 0x0
    s_mov_b32 s46, s44
L_nc:
    s_load_dword s40, s[4:5], s17
    s_load_dword s41, s[6:7], s17
    s_branch L_r0
L_slow:
    s_cmp_ge_u32 s27, 8
    s_cbranch_scc1 L_poll0
    s_atomic_cmpswap s[46:47], s[10:11], 0x0
L_poll0:
    s_movk_i32 s23, 256
L_poll:
    global_load_dword v1, v3, s[10:11] sc1
    s_waitcnt vmcnt(0)
    v_readfirstlane_b32 s22, v1
    s_cmp_lg_u32 s22, 0
    s_cbranch_scc1 L_got
    s_sub_u32 s23, s23, 1
    s_cmp_lg_u32 s23, 0
    s_cbranch_scc1 L_poll
    s_mov_b32 s22, 8
    s_atomic_cmpswap s[22:23], s[10:11], 0x0 glc
    s_waitcnt lgkmcnt(0)
    s_max_u32 s22, s22, 8
    s_branch L_got
L_r0:
    s_waitcnt vmcnt(1)
    v_readfirstlane_b32 s16, v32
    buffer_load_dwordx4 v[40:43], v2, s[12:15], s33 offen nt
    buffer_load_dwordx4 v[44:47], v2, s[12:15], s33 offen offset:1024 nt
    s_lshl_b32 s16, s16, 16
    v_dot2_f32_bf16 v16, v32, v14, s16 neg_lo:[0,0,1]
    v_dot2_f32_bf16 v17, v32, v15, s16 neg_lo:[0,0,1]
    v_dot2_f32_bf16 v18, v33, v14, s16 neg_lo:[0,0,1]
    v_dot2_f32_bf16 v19, v33, v15, s16 neg_lo:[0,0,1]
    v_dot2_f32_bf16 v20, v34, v14, s16 neg_lo:[0,0,1]
    v_dot2_f32_bf16 v21, v34, v15, s16 neg_lo:[0,0,1]
    v_dot2_f32_bf16 v22, v35, v14, s16 neg_lo:[0,0,1]
    v_dot2_f32_bf16 v23, v35, v15, s16 neg_lo:[0,0,1]
    v_pk_mul_f32 v[8:9], v[16:17], v[16:17]
    v_pk_add_f32 v[6:7], v[16:17], v[18:19]
    v_pk_fma_f32 v[8:9], v[18:19], v[18:19], v[8:9]
    v_pk_add_f32 v[6:7], v[6:7], v[20:21]
    v_pk_fma_f32 v[8:9], v[20:21], v[20:21], v[8:9]
    v_pk_add_f32 v[6:7], v[6:7], v[22:23]
    v_pk_fma_f32 v[8:9], v[22:23], v[22:23], v[8:9]
    s_waitcnt vmcnt(2)
    v_dot2_f32_bf16 v24, v36, v14, s16 neg_lo:[0,0,1]
    v_dot2_f32_bf16 v25, v36, v15, s16 neg_lo:[0,0,1]
    v_dot2_f32_bf16 v26, v37, v14, s16 neg_lo:[0,0,1]
    v_dot2_f32_bf16 v27, v37, v15, s16 neg_lo:[0,0,1]
    v_dot2_f32_bf16 v28, v38, v14, s16 neg_lo:[0,0,1]
    v_dot2_f32_bf16 v29, v38, v15, s16 neg_lo:[0,0,1]
    v_dot2_f32_bf16 v30, v39, v14, s16 neg_lo:[0,0,1]
    v_dot2_f32_bf16 v31, v39, v15, s16 neg_lo:[0,0,1]
    v_pk_add_f32 v[6:7], v[6:7], v[24:25]
    v_pk_fma_f32 v[8:9], v[24:25], v[24:25], v[8:9]
    v_pk_add_f32 v[6:7], v[6:7], v[26:27]
    v_pk_fma_f32 v[8:9], v[26:27], v[26:27], v[8:9]
    v_pk_add_f32 v[6:7], v[6:7], v[28:29]
    v_pk_fma_f32 v[8:9], v[28:29], v[28:29], v[8:9]
    v_pk_add_f32 v[6:7], v[6:7], v[30:31]
    v_pk_fma_f32 v[8:9], v[30:31], v[30:31], v[8:9]
    v_add_f32 v6, v6, v7
    v_add_f32 v8, v8, v9
    v_mov_b32 v10, s16
    v_add_f32_dpp v6, v6, v6 row_ror:8 row_mask:0xf bank_mask:0xf
    v_add_f32_dpp v8, v8, v8 row_ror:8 row_mask:0xf bank_mask:0xf
    s_waitcnt lgkmcnt(0)
    v_add_f32_dpp v6, v6, v6 row_ror:4 row_mask:0xf bank_mask:0xf
    v_add_f32_dpp v8, v8, v8 row_ror:4 row_mask:0xf bank_mask:0xf
    s_lshl_b32 s40, s40, s24
    v_add_f32_dpp v6, v6, v6 row_ror:2 row_mask:0xf bank_mask:0xf
    v_add_f32_dpp v8, v8, v8 row_ror:2 row_mask:0xf bank_mask:0xf
    s_lshl_b32 s41, s41, s24
    v_add_f32_dpp v6, v6, v6 row_ror:1 row_mask:0xf bank_mask:0xf
    v_add_f32_dpp v8, v8, v8 row_ror:1 row_mask:0xf bank_mask:0xf
    s_and_b32 s40, s40, s26
    v_add_f32_dpp v6, v6, v6 row_bcast:15 row_mask:0xa bank_mask:0xf
    v_add_f32_dpp v8, v8, v8 row_bcast:15 row_mask:0xa bank_mask:0xf
    s_and_b32 s41, s41, s26
    v_add_f32_dpp v6, v6, v6 row_bcast:31 row_mask:0xc bank_mask:0xf
    v_add_f32_dpp v8, v8, v8 row_bcast:31 row_mask:0xc bank_mask:0xf
    v_readlane_b32 s42, v6, 63
    v_readlane_b32 s43, v8, 63
    s_nop 0
    v_fma_f32 v6, s42, -v4, v10
    v_add_f32 v7, s42, s42
    v_cvt_pk_bf16_f32 v6, 0, v6
    v_sub_f32 v6, v6, v10
    v_fma_f32 v7, v6, s25, -v7
    v_fma_f32 v8, v6, v7, s43
    v_cvt_pk_bf16_f32 v8, 0, v8
    v_fma_f32 v8, v8, -v4, v5
    v_cvt_pk_bf16_f32 v8, 0, v8
    v_sqrt_f32 v8, v8
    s_nop 0
    v_cvt_pk_bf16_f32 v8, 0, v8
    v_rcp_f32 v8, v8
    s_nop 0
    v_mul_f32 v12, s40, v8
    v_fma_f32 v13, -v6, v12, s41
    v_pk_fma_f32 v[16:17], v[16:17], v[12:13], v[12:13] op_sel:[0,0,1] op_sel_hi:[1,0,1]
    v_pk_fma_f32 v[18:19], v[18:19], v[12:13], v[12:13] op_sel:[0,0,1] op_sel_hi:[1,0,1]
    v_pk_fma_f32 v[20:21], v[20:21], v[12:13], v[12:13] op_sel:[0,0,1] op_sel_hi:[1,0,1]
    v_pk_fma_f32 v[22:23], v[22:23], v[12:13], v[12:13] op_sel:[0,0,1] op_sel_hi:[1,0,1]
    v_cvt_pk_bf16_f32 v32, v16, v17
    v_cvt_pk_bf16_f32 v33, v18, v19
    v_cvt_pk_bf16_f32 v34, v20, v21
    v_cvt_pk_bf16_f32 v35, v22, v23
    buffer_store_dwordx4 v[32:35], v2, s[28:31], s32 offen sc1
    v_pk_fma_f32 v[24:25], v[24:25], v[12:13], v[12:13] op_sel:[0,0,1] op_sel_hi:[1,0,1]
    v_pk_fma_f32 v[26:27], v[26:27], v[12:13], v[12:13] op_sel:[0,0,1] op_sel_hi:[1,0,1]
    v_pk_fma_f32 v[28:29], v[28:29], v[12:13], v[12:13] op_sel:[0,0,1] op_sel_hi:[1,0,1]
    v_pk_fma_f32 v[30:31], v[30:31], v[12:13], v[12:13] op_sel:[0,0,1] op_sel_hi:[1,0,1]
    v_cvt_pk_bf16_f32 v36, v24, v25
    v_cvt_pk_bf16_f32 v37, v26, v27
    v_cvt_pk_bf16_f32 v38, v28, v29
    v_cvt_pk_bf16_f32 v39, v30, v31
    buffer_store_dwordx4 v[36:39], v2, s[28:31], s32 offen offset:1024 sc1
    s_lshr_b32 s21, s20, 6
    s_and_b32 s23, s21, 4
    s_add_u32 s23, s23, s21
    s_and_b32 s21, s23, 11
    s_lshr_b32 s23, s2, 3
    s_lshl_b32 s34, s23, 6
    s_or_b32 s34, s34, s21
    s_load_dword s22, s[10:11], 0x0
    s_waitcnt lgkmcnt(0)
    s_cmp_eq_u32 s22, 0
    s_cbranch_scc1 L_slow
L_got:
    s_add_u32 s22, s22, s2
    s_lshr_b32 s23, s2, 5
    s_xor_b32 s23, s23, s22
    s_and_b32 s23, s23, 4
    s_or_b32 s34, s34, s23
    s_and_b32 s22, s22, 3
    s_lshl_b32 s22, s22, 4
    s_or_b32 s34, s34, s22
    s_lshl_b32 s34, s34, 11
    s_add_u32 s34, s34, 8388608
    s_add_u32 s35, s34, 4194304
    buffer_load_dwordx4 v[48:51], v2, s[12:15], s34 offen nt
L_r1:
    s_waitcnt vmcnt(4)
    v_readfirstlane_b32 s16, v40
    buffer_load_dwordx4 v[52:55], v2, s[12:15], s34 offen offset:1024 nt
    s_lshl_b32 s16, s16, 16
    v_dot2_f32_bf16 v16, v40, v14, s16 neg_lo:[0,0,1]
    v_dot2_f32_bf16 v17, v40, v15, s16 neg_lo:[0,0,1]
    v_dot2_f32_bf16 v18, v41, v14, s16 neg_lo:[0,0,1]
    v_dot2_f32_bf16 v19, v41, v15, s16 neg_lo:[0,0,1]
    v_dot2_f32_bf16 v20, v42, v14, s16 neg_lo:[0,0,1]
    v_dot2_f32_bf16 v21, v42, v15, s16 neg_lo:[0,0,1]
    v_dot2_f32_bf16 v22, v43, v14, s16 neg_lo:[0,0,1]
    v_dot2_f32_bf16 v23, v43, v15, s16 neg_lo:[0,0,1]
    v_pk_mul_f32 v[8:9], v[16:17], v[16:17]
    v_pk_add_f32 v[6:7], v[16:17], v[18:19]
    v_pk_fma_f32 v[8:9], v[18:19], v[18:19], v[8:9]
    v_pk_add_f32 v[6:7], v[6:7], v[20:21]
    v_pk_fma_f32 v[8:9], v[20:21], v[20:21], v[8:9]
    v_pk_add_f32 v[6:7], v[6:7], v[22:23]
    v_pk_fma_f32 v[8:9], v[22:23], v[22:23], v[8:9]
    s_waitcnt vmcnt(4)
    buffer_load_dwordx4 v[32:35], v2, s[12:15], s35 offen nt
    v_dot2_f32_bf16 v24, v44, v14, s16 neg_lo:[0,0,1]
    v_dot2_f32_bf16 v25, v44, v15, s16 neg_lo:[0,0,1]
    v_dot2_f32_bf16 v26, v45, v14, s16 neg_lo:[0,0,1]
    v_dot2_f32_bf16 v27, v45, v15, s16 neg_lo:[0,0,1]
    v_dot2_f32_bf16 v28, v46, v14, s16 neg_lo:[0,0,1]
    v_dot2_f32_bf16 v29, v46, v15, s16 neg_lo:[0,0,1]
    v_dot2_f32_bf16 v30, v47, v14, s16 neg_lo:[0,0,1]
    v_dot2_f32_bf16 v31, v47, v15, s16 neg_lo:[0,0,1]
    v_pk_add_f32 v[6:7], v[6:7], v[24:25]
    v_pk_fma_f32 v[8:9], v[24:25], v[24:25], v[8:9]
    v_pk_add_f32 v[6:7], v[6:7], v[26:27]
    v_pk_fma_f32 v[8:9], v[26:27], v[26:27], v[8:9]
    v_pk_add_f32 v[6:7], v[6:7], v[28:29]
    v_pk_fma_f32 v[8:9], v[28:29], v[28:29], v[8:9]
    v_pk_add_f32 v[6:7], v[6:7], v[30:31]
    v_pk_fma_f32 v[8:9], v[30:31], v[30:31], v[8:9]
    v_add_f32 v6, v6, v7
    v_add_f32 v8, v8, v9
    v_mov_b32 v10, s16
    v_add_f32_dpp v6, v6, v6 row_ror:8 row_mask:0xf bank_mask:0xf
    v_add_f32_dpp v8, v8, v8 row_ror:8 row_mask:0xf bank_mask:0xf
    s_nop 0
    v_add_f32_dpp v6, v6, v6 row_ror:4 row_mask:0xf bank_mask:0xf
    v_add_f32_dpp v8, v8, v8 row_ror:4 row_mask:0xf bank_mask:0xf
    s_nop 0
    v_add_f32_dpp v6, v6, v6 row_ror:2 row_mask:0xf bank_mask:0xf
    v_add_f32_dpp v8, v8, v8 row_ror:2 row_mask:0xf bank_mask:0xf
    s_nop 0
    v_add_f32_dpp v6, v6, v6 row_ror:1 row_mask:0xf bank_mask:0xf
    v_add_f32_dpp v8, v8, v8 row_ror:1 row_mask:0xf bank_mask:0xf
    s_nop 0
    v_add_f32_dpp v6, v6, v6 row_bcast:15 row_mask:0xa bank_mask:0xf
    v_add_f32_dpp v8, v8, v8 row_bcast:15 row_mask:0xa bank_mask:0xf
    s_nop 0
    v_add_f32_dpp v6, v6, v6 row_bcast:31 row_mask:0xc bank_mask:0xf
    v_add_f32_dpp v8, v8, v8 row_bcast:31 row_mask:0xc bank_mask:0xf
    v_readlane_b32 s42, v6, 63
    v_readlane_b32 s43, v8, 63
    s_nop 0
    v_fma_f32 v6, s42, -v4, v10
    v_add_f32 v7, s42, s42
    v_cvt_pk_bf16_f32 v6, 0, v6
    v_sub_f32 v6, v6, v10
    v_fma_f32 v7, v6, s25, -v7
    v_fma_f32 v8, v6, v7, s43
    v_cvt_pk_bf16_f32 v8, 0, v8
    v_fma_f32 v8, v8, -v4, v5
    v_cvt_pk_bf16_f32 v8, 0, v8
    v_sqrt_f32 v8, v8
    s_nop 0
    v_cvt_pk_bf16_f32 v8, 0, v8
    v_rcp_f32 v8, v8
    s_nop 0
    v_mul_f32 v12, s40, v8
    v_fma_f32 v13, -v6, v12, s41
    v_pk_fma_f32 v[16:17], v[16:17], v[12:13], v[12:13] op_sel:[0,0,1] op_sel_hi:[1,0,1]
    v_pk_fma_f32 v[18:19], v[18:19], v[12:13], v[12:13] op_sel:[0,0,1] op_sel_hi:[1,0,1]
    v_pk_fma_f32 v[20:21], v[20:21], v[12:13], v[12:13] op_sel:[0,0,1] op_sel_hi:[1,0,1]
    v_pk_fma_f32 v[22:23], v[22:23], v[12:13], v[12:13] op_sel:[0,0,1] op_sel_hi:[1,0,1]
    v_cvt_pk_bf16_f32 v40, v16, v17
    v_cvt_pk_bf16_f32 v41, v18, v19
    v_cvt_pk_bf16_f32 v42, v20, v21
    v_cvt_pk_bf16_f32 v43, v22, v23
    buffer_store_dwordx4 v[40:43], v2, s[28:31], s33 offen sc1
    v_pk_fma_f32 v[24:25], v[24:25], v[12:13], v[12:13] op_sel:[0,0,1] op_sel_hi:[1,0,1]
    v_pk_fma_f32 v[26:27], v[26:27], v[12:13], v[12:13] op_sel:[0,0,1] op_sel_hi:[1,0,1]
    v_pk_fma_f32 v[28:29], v[28:29], v[12:13], v[12:13] op_sel:[0,0,1] op_sel_hi:[1,0,1]
    v_pk_fma_f32 v[30:31], v[30:31], v[12:13], v[12:13] op_sel:[0,0,1] op_sel_hi:[1,0,1]
    v_cvt_pk_bf16_f32 v44, v24, v25
    v_cvt_pk_bf16_f32 v45, v26, v27
    v_cvt_pk_bf16_f32 v46, v28, v29
    v_cvt_pk_bf16_f32 v47, v30, v31
    buffer_store_dwordx4 v[44:47], v2, s[28:31], s33 offen offset:1024 sc1
L_r2:
    s_lshr_b32 s21, s34, 10
    s_and_b32 s21, s21, 0x3fc
    s_load_dword s40, s[4:5], s21
    s_load_dword s41, s[6:7], s21
    s_add_u32 s36, s34, 8388608
    s_add_u32 s37, s34, 12582912
    s_waitcnt vmcnt(4)
    v_readfirstlane_b32 s16, v48
    buffer_load_dwordx4 v[36:39], v2, s[12:15], s35 offen offset:1024 nt
    s_lshl_b32 s16, s16, 16
    v_dot2_f32_bf16 v16, v48, v14, s16 neg_lo:[0,0,1]
    v_dot2_f32_bf16 v17, v48, v15, s16 neg_lo:[0,0,1]
    v_dot2_f32_bf16 v18, v49, v14, s16 neg_lo:[0,0,1]
    v_dot2_f32_bf16 v19, v49, v15, s16 neg_lo:[0,0,1]
    v_dot2_f32_bf16 v20, v50, v14, s16 neg_lo:[0,0,1]
    v_dot2_f32_bf16 v21, v50, v15, s16 neg_lo:[0,0,1]
    v_dot2_f32_bf16 v22, v51, v14, s16 neg_lo:[0,0,1]
    v_dot2_f32_bf16 v23, v51, v15, s16 neg_lo:[0,0,1]
    v_pk_mul_f32 v[8:9], v[16:17], v[16:17]
    v_pk_add_f32 v[6:7], v[16:17], v[18:19]
    v_pk_fma_f32 v[8:9], v[18:19], v[18:19], v[8:9]
    v_pk_add_f32 v[6:7], v[6:7], v[20:21]
    v_pk_fma_f32 v[8:9], v[20:21], v[20:21], v[8:9]
    v_pk_add_f32 v[6:7], v[6:7], v[22:23]
    v_pk_fma_f32 v[8:9], v[22:23], v[22:23], v[8:9]
    s_waitcnt vmcnt(4)
    buffer_load_dwordx4 v[40:43], v2, s[12:15], s36 offen nt
    v_dot2_f32_bf16 v24, v52, v14, s16 neg_lo:[0,0,1]
    v_dot2_f32_bf16 v25, v52, v15, s16 neg_lo:[0,0,1]
    v_dot2_f32_bf16 v26, v53, v14, s16 neg_lo:[0,0,1]
    v_dot2_f32_bf16 v27, v53, v15, s16 neg_lo:[0,0,1]
    v_dot2_f32_bf16 v28, v54, v14, s16 neg_lo:[0,0,1]
    v_dot2_f32_bf16 v29, v54, v15, s16 neg_lo:[0,0,1]
    v_dot2_f32_bf16 v30, v55, v14, s16 neg_lo:[0,0,1]
    v_dot2_f32_bf16 v31, v55, v15, s16 neg_lo:[0,0,1]
    v_pk_add_f32 v[6:7], v[6:7], v[24:25]
    v_pk_fma_f32 v[8:9], v[24:25], v[24:25], v[8:9]
    v_pk_add_f32 v[6:7], v[6:7], v[26:27]
    v_pk_fma_f32 v[8:9], v[26:27], v[26:27], v[8:9]
    v_pk_add_f32 v[6:7], v[6:7], v[28:29]
    v_pk_fma_f32 v[8:9], v[28:29], v[28:29], v[8:9]
    v_pk_add_f32 v[6:7], v[6:7], v[30:31]
    v_pk_fma_f32 v[8:9], v[30:31], v[30:31], v[8:9]
    v_add_f32 v6, v6, v7
    v_add_f32 v8, v8, v9
    v_mov_b32 v10, s16
    v_add_f32_dpp v6, v6, v6 row_ror:8 row_mask:0xf bank_mask:0xf
    v_add_f32_dpp v8, v8, v8 row_ror:8 row_mask:0xf bank_mask:0xf
    s_waitcnt lgkmcnt(0)
    v_add_f32_dpp v6, v6, v6 row_ror:4 row_mask:0xf bank_mask:0xf
    v_add_f32_dpp v8, v8, v8 row_ror:4 row_mask:0xf bank_mask:0xf
    s_lshl_b32 s40, s40, s24
    v_add_f32_dpp v6, v6, v6 row_ror:2 row_mask:0xf bank_mask:0xf
    v_add_f32_dpp v8, v8, v8 row_ror:2 row_mask:0xf bank_mask:0xf
    s_lshl_b32 s41, s41, s24
    v_add_f32_dpp v6, v6, v6 row_ror:1 row_mask:0xf bank_mask:0xf
    v_add_f32_dpp v8, v8, v8 row_ror:1 row_mask:0xf bank_mask:0xf
    s_and_b32 s40, s40, s26
    v_add_f32_dpp v6, v6, v6 row_bcast:15 row_mask:0xa bank_mask:0xf
    v_add_f32_dpp v8, v8, v8 row_bcast:15 row_mask:0xa bank_mask:0xf
    s_and_b32 s41, s41, s26
    v_add_f32_dpp v6, v6, v6 row_bcast:31 row_mask:0xc bank_mask:0xf
    v_add_f32_dpp v8, v8, v8 row_bcast:31 row_mask:0xc bank_mask:0xf
    v_readlane_b32 s42, v6, 63
    v_readlane_b32 s43, v8, 63
    s_nop 0
    v_fma_f32 v6, s42, -v4, v10
    v_add_f32 v7, s42, s42
    v_cvt_pk_bf16_f32 v6, 0, v6
    v_sub_f32 v6, v6, v10
    v_fma_f32 v7, v6, s25, -v7
    v_fma_f32 v8, v6, v7, s43
    v_cvt_pk_bf16_f32 v8, 0, v8
    v_fma_f32 v8, v8, -v4, v5
    v_cvt_pk_bf16_f32 v8, 0, v8
    v_sqrt_f32 v8, v8
    s_nop 0
    v_cvt_pk_bf16_f32 v8, 0, v8
    v_rcp_f32 v8, v8
    s_nop 0
    v_mul_f32 v12, s40, v8
    v_fma_f32 v13, -v6, v12, s41
    v_pk_fma_f32 v[16:17], v[16:17], v[12:13], v[12:13] op_sel:[0,0,1] op_sel_hi:[1,0,1]
    v_pk_fma_f32 v[18:19], v[18:19], v[12:13], v[12:13] op_sel:[0,0,1] op_sel_hi:[1,0,1]
    v_pk_fma_f32 v[20:21], v[20:21], v[12:13], v[12:13] op_sel:[0,0,1] op_sel_hi:[1,0,1]
    v_pk_fma_f32 v[22:23], v[22:23], v[12:13], v[12:13] op_sel:[0,0,1] op_sel_hi:[1,0,1]
    v_cvt_pk_bf16_f32 v48, v16, v17
    v_cvt_pk_bf16_f32 v49, v18, v19
    v_cvt_pk_bf16_f32 v50, v20, v21
    v_cvt_pk_bf16_f32 v51, v22, v23
    buffer_store_dwordx4 v[48:51], v2, s[28:31], s34 offen sc1
    v_pk_fma_f32 v[24:25], v[24:25], v[12:13], v[12:13] op_sel:[0,0,1] op_sel_hi:[1,0,1]
    v_pk_fma_f32 v[26:27], v[26:27], v[12:13], v[12:13] op_sel:[0,0,1] op_sel_hi:[1,0,1]
    v_pk_fma_f32 v[28:29], v[28:29], v[12:13], v[12:13] op_sel:[0,0,1] op_sel_hi:[1,0,1]
    v_pk_fma_f32 v[30:31], v[30:31], v[12:13], v[12:13] op_sel:[0,0,1] op_sel_hi:[1,0,1]
    v_cvt_pk_bf16_f32 v52, v24, v25
    v_cvt_pk_bf16_f32 v53, v26, v27
    v_cvt_pk_bf16_f32 v54, v28, v29
    v_cvt_pk_bf16_f32 v55, v30, v31
    buffer_store_dwordx4 v[52:55], v2, s[28:31], s34 offen offset:1024 sc1
L_r3:
    s_add_u32 s38, s34, 16777216
    s_waitcnt vmcnt(6)
    v_readfirstlane_b32 s16, v32
    buffer_load_dwordx4 v[44:47], v2, s[12:15], s36 offen offset:1024 nt
    s_lshl_b32 s16, s16, 16
    v_dot2_f32_bf16 v16, v32, v14, s16 neg_lo:[0,0,1]
    v_dot2_f32_bf16 v17, v32, v15, s16 neg_lo:[0,0,1]
    v_dot2_f32_bf16 v18, v33, v14, s16 neg_lo:[0,0,1]
    v_dot2_f32_bf16 v19, v33, v15, s16 neg_lo:[0,0,1]
    v_dot2_f32_bf16 v20, v34, v14, s16 neg_lo:[0,0,1]
    v_dot2_f32_bf16 v21, v34, v15, s16 neg_lo:[0,0,1]
    v_dot2_f32_bf16 v22, v35, v14, s16 neg_lo:[0,0,1]
    v_dot2_f32_bf16 v23, v35, v15, s16 neg_lo:[0,0,1]
    v_pk_mul_f32 v[8:9], v[16:17], v[16:17]
    v_pk_add_f32 v[6:7], v[16:17], v[18:19]
    v_pk_fma_f32 v[8:9], v[18:19], v[18:19], v[8:9]
    v_pk_add_f32 v[6:7], v[6:7], v[20:21]
    v_pk_fma_f32 v[8:9], v[20:21], v[20:21], v[8:9]
    v_pk_add_f32 v[6:7], v[6:7], v[22:23]
    v_pk_fma_f32 v[8:9], v[22:23], v[22:23], v[8:9]
    s_waitcnt vmcnt(4)
    buffer_load_dwordx4 v[48:51], v2, s[12:15], s37 offen nt
    v_dot2_f32_bf16 v24, v36, v14, s16 neg_lo:[0,0,1]
    v_dot2_f32_bf16 v25, v36, v15, s16 neg_lo:[0,0,1]
    v_dot2_f32_bf16 v26, v37, v14, s16 neg_lo:[0,0,1]
    v_dot2_f32_bf16 v27, v37, v15, s16 neg_lo:[0,0,1]
    v_dot2_f32_bf16 v28, v38, v14, s16 neg_lo:[0,0,1]
    v_dot2_f32_bf16 v29, v38, v15, s16 neg_lo:[0,0,1]
    v_dot2_f32_bf16 v30, v39, v14, s16 neg_lo:[0,0,1]
    v_dot2_f32_bf16 v31, v39, v15, s16 neg_lo:[0,0,1]
    v_pk_add_f32 v[6:7], v[6:7], v[24:25]
    v_pk_fma_f32 v[8:9], v[24:25], v[24:25], v[8:9]
    v_pk_add_f32 v[6:7], v[6:7], v[26:27]
    v_pk_fma_f32 v[8:9], v[26:27], v[26:27], v[8:9]
    v_pk_add_f32 v[6:7], v[6:7], v[28:29]
    v_pk_fma_f32 v[8:9], v[28:29], v[28:29], v[8:9]
    v_pk_add_f32 v[6:7], v[6:7], v[30:31]
    v_pk_fma_f32 v[8:9], v[30:31], v[30:31], v[8:9]
    v_add_f32 v6, v6, v7
    v_add_f32 v8, v8, v9
    v_mov_b32 v10, s16
    v_add_f32_dpp v6, v6, v6 row_ror:8 row_mask:0xf bank_mask:0xf
    v_add_f32_dpp v8, v8, v8 row_ror:8 row_mask:0xf bank_mask:0xf
    s_nop 0
    v_add_f32_dpp v6, v6, v6 row_ror:4 row_mask:0xf bank_mask:0xf
    v_add_f32_dpp v8, v8, v8 row_ror:4 row_mask:0xf bank_mask:0xf
    s_nop 0
    v_add_f32_dpp v6, v6, v6 row_ror:2 row_mask:0xf bank_mask:0xf
    v_add_f32_dpp v8, v8, v8 row_ror:2 row_mask:0xf bank_mask:0xf
    s_nop 0
    v_add_f32_dpp v6, v6, v6 row_ror:1 row_mask:0xf bank_mask:0xf
    v_add_f32_dpp v8, v8, v8 row_ror:1 row_mask:0xf bank_mask:0xf
    s_nop 0
    v_add_f32_dpp v6, v6, v6 row_bcast:15 row_mask:0xa bank_mask:0xf
    v_add_f32_dpp v8, v8, v8 row_bcast:15 row_mask:0xa bank_mask:0xf
    s_nop 0
    v_add_f32_dpp v6, v6, v6 row_bcast:31 row_mask:0xc bank_mask:0xf
    v_add_f32_dpp v8, v8, v8 row_bcast:31 row_mask:0xc bank_mask:0xf
    v_readlane_b32 s42, v6, 63
    v_readlane_b32 s43, v8, 63
    s_nop 0
    v_fma_f32 v6, s42, -v4, v10
    v_add_f32 v7, s42, s42
    v_cvt_pk_bf16_f32 v6, 0, v6
    v_sub_f32 v6, v6, v10
    v_fma_f32 v7, v6, s25, -v7
    v_fma_f32 v8, v6, v7, s43
    v_cvt_pk_bf16_f32 v8, 0, v8
    v_fma_f32 v8, v8, -v4, v5
    v_cvt_pk_bf16_f32 v8, 0, v8
    v_sqrt_f32 v8, v8
    s_nop 0
    v_cvt_pk_bf16_f32 v8, 0, v8
    v_rcp_f32 v8, v8
    s_nop 0
    v_mul_f32 v12, s40, v8
    v_fma_f32 v13, -v6, v12, s41
    v_pk_fma_f32 v[16:17], v[16:17], v[12:13], v[12:13] op_sel:[0,0,1] op_sel_hi:[1,0,1]
    v_pk_fma_f32 v[18:19], v[18:19], v[12:13], v[12:13] op_sel:[0,0,1] op_sel_hi:[1,0,1]
    v_pk_fma_f32 v[20:21], v[20:21], v[12:13], v[12:13] op_sel:[0,0,1] op_sel_hi:[1,0,1]
    v_pk_fma_f32 v[22:23], v[22:23], v[12:13], v[12:13] op_sel:[0,0,1] op_sel_hi:[1,0,1]
    v_cvt_pk_bf16_f32 v32, v16, v17
    v_cvt_pk_bf16_f32 v33, v18, v19
    v_cvt_pk_bf16_f32 v34, v20, v21
    v_cvt_pk_bf16_f32 v35, v22, v23
    buffer_store_dwordx4 v[32:35], v2, s[28:31], s35 offen sc1
    v_pk_fma_f32 v[24:25], v[24:25], v[12:13], v[12:13] op_sel:[0,0,1] op_sel_hi:[1,0,1]
    v_pk_fma_f32 v[26:27], v[26:27], v[12:13], v[12:13] op_sel:[0,0,1] op_sel_hi:[1,0,1]
    v_pk_fma_f32 v[28:29], v[28:29], v[12:13], v[12:13] op_sel:[0,0,1] op_sel_hi:[1,0,1]
    v_pk_fma_f32 v[30:31], v[30:31], v[12:13], v[12:13] op_sel:[0,0,1] op_sel_hi:[1,0,1]
    v_cvt_pk_bf16_f32 v36, v24, v25
    v_cvt_pk_bf16_f32 v37, v26, v27
    v_cvt_pk_bf16_f32 v38, v28, v29
    v_cvt_pk_bf16_f32 v39, v30, v31
    buffer_store_dwordx4 v[36:39], v2, s[28:31], s35 offen offset:1024 sc1
L_r4:
    s_add_u32 s39, s34, 20971520
    s_waitcnt vmcnt(6)
    v_readfirstlane_b32 s16, v40
    buffer_load_dwordx4 v[52:55], v2, s[12:15], s37 offen offset:1024 nt
    s_lshl_b32 s16, s16, 16
    v_dot2_f32_bf16 v16, v40, v14, s16 neg_lo:[0,0,1]
    v_dot2_f32_bf16 v17, v40, v15, s16 neg_lo:[0,0,1]
    v_dot2_f32_bf16 v18, v41, v14, s16 neg_lo:[0,0,1]
    v_dot2_f32_bf16 v19, v41, v15, s16 neg_lo:[0,0,1]
    v_dot2_f32_bf16 v20, v42, v14, s16 neg_lo:[0,0,1]
    v_dot2_f32_bf16 v21, v42, v15, s16 neg_lo:[0,0,1]
    v_dot2_f32_bf16 v22, v43, v14, s16 neg_lo:[0,0,1]
    v_dot2_f32_bf16 v23, v43, v15, s16 neg_lo:[0,0,1]
    v_pk_mul_f32 v[8:9], v[16:17], v[16:17]
    v_pk_add_f32 v[6:7], v[16:17], v[18:19]
    v_pk_fma_f32 v[8:9], v[18:19], v[18:19], v[8:9]
    v_pk_add_f32 v[6:7], v[6:7], v[20:21]
    v_pk_fma_f32 v[8:9], v[20:21], v[20:21], v[8:9]
    v_pk_add_f32 v[6:7], v[6:7], v[22:23]
    v_pk_fma_f32 v[8:9], v[22:23], v[22:23], v[8:9]
    s_waitcnt vmcnt(4)
    buffer_load_dwordx4 v[32:35], v2, s[12:15], s38 offen nt
    v_dot2_f32_bf16 v24, v44, v14, s16 neg_lo:[0,0,1]
    v_dot2_f32_bf16 v25, v44, v15, s16 neg_lo:[0,0,1]
    v_dot2_f32_bf16 v26, v45, v14, s16 neg_lo:[0,0,1]
    v_dot2_f32_bf16 v27, v45, v15, s16 neg_lo:[0,0,1]
    v_dot2_f32_bf16 v28, v46, v14, s16 neg_lo:[0,0,1]
    v_dot2_f32_bf16 v29, v46, v15, s16 neg_lo:[0,0,1]
    v_dot2_f32_bf16 v30, v47, v14, s16 neg_lo:[0,0,1]
    v_dot2_f32_bf16 v31, v47, v15, s16 neg_lo:[0,0,1]
    v_pk_add_f32 v[6:7], v[6:7], v[24:25]
    v_pk_fma_f32 v[8:9], v[24:25], v[24:25], v[8:9]
    v_pk_add_f32 v[6:7], v[6:7], v[26:27]
    v_pk_fma_f32 v[8:9], v[26:27], v[26:27], v[8:9]
    v_pk_add_f32 v[6:7], v[6:7], v[28:29]
    v_pk_fma_f32 v[8:9], v[28:29], v[28:29], v[8:9]
    v_pk_add_f32 v[6:7], v[6:7], v[30:31]
    v_pk_fma_f32 v[8:9], v[30:31], v[30:31], v[8:9]
    v_add_f32 v6, v6, v7
    v_add_f32 v8, v8, v9
    v_mov_b32 v10, s16
    v_add_f32_dpp v6, v6, v6 row_ror:8 row_mask:0xf bank_mask:0xf
    v_add_f32_dpp v8, v8, v8 row_ror:8 row_mask:0xf bank_mask:0xf
    s_nop 0
    v_add_f32_dpp v6, v6, v6 row_ror:4 row_mask:0xf bank_mask:0xf
    v_add_f32_dpp v8, v8, v8 row_ror:4 row_mask:0xf bank_mask:0xf
    s_nop 0
    v_add_f32_dpp v6, v6, v6 row_ror:2 row_mask:0xf bank_mask:0xf
    v_add_f32_dpp v8, v8, v8 row_ror:2 row_mask:0xf bank_mask:0xf
    s_nop 0
    v_add_f32_dpp v6, v6, v6 row_ror:1 row_mask:0xf bank_mask:0xf
    v_add_f32_dpp v8, v8, v8 row_ror:1 row_mask:0xf bank_mask:0xf
    s_nop 0
    v_add_f32_dpp v6, v6, v6 row_bcast:15 row_mask:0xa bank_mask:0xf
    v_add_f32_dpp v8, v8, v8 row_bcast:15 row_mask:0xa bank_mask:0xf
    s_nop 0
    v_add_f32_dpp v6, v6, v6 row_bcast:31 row_mask:0xc bank_mask:0xf
    v_add_f32_dpp v8, v8, v8 row_bcast:31 row_mask:0xc bank_mask:0xf
    v_readlane_b32 s42, v6, 63
    v_readlane_b32 s43, v8, 63
    s_nop 0
    v_fma_f32 v6, s42, -v4, v10
    v_add_f32 v7, s42, s42
    v_cvt_pk_bf16_f32 v6, 0, v6
    v_sub_f32 v6, v6, v10
    v_fma_f32 v7, v6, s25, -v7
    v_fma_f32 v8, v6, v7, s43
    v_cvt_pk_bf16_f32 v8, 0, v8
    v_fma_f32 v8, v8, -v4, v5
    v_cvt_pk_bf16_f32 v8, 0, v8
    v_sqrt_f32 v8, v8
    s_nop 0
    v_cvt_pk_bf16_f32 v8, 0, v8
    v_rcp_f32 v8, v8
    s_nop 0
    v_mul_f32 v12, s40, v8
    v_fma_f32 v13, -v6, v12, s41
    v_pk_fma_f32 v[16:17], v[16:17], v[12:13], v[12:13] op_sel:[0,0,1] op_sel_hi:[1,0,1]
    v_pk_fma_f32 v[18:19], v[18:19], v[12:13], v[12:13] op_sel:[0,0,1] op_sel_hi:[1,0,1]
    v_pk_fma_f32 v[20:21], v[20:21], v[12:13], v[12:13] op_sel:[0,0,1] op_sel_hi:[1,0,1]
    v_pk_fma_f32 v[22:23], v[22:23], v[12:13], v[12:13] op_sel:[0,0,1] op_sel_hi:[1,0,1]
    v_cvt_pk_bf16_f32 v40, v16, v17
    v_cvt_pk_bf16_f32 v41, v18, v19
    v_cvt_pk_bf16_f32 v42, v20, v21
    v_cvt_pk_bf16_f32 v43, v22, v23
    buffer_store_dwordx4 v[40:43], v2, s[28:31], s36 offen sc1
    v_pk_fma_f32 v[24:25], v[24:25], v[12:13], v[12:13] op_sel:[0,0,1] op_sel_hi:[1,0,1]
    v_pk_fma_f32 v[26:27], v[26:27], v[12:13], v[12:13] op_sel:[0,0,1] op_sel_hi:[1,0,1]
    v_pk_fma_f32 v[28:29], v[28:29], v[12:13], v[12:13] op_sel:[0,0,1] op_sel_hi:[1,0,1]
    v_pk_fma_f32 v[30:31], v[30:31], v[12:13], v[12:13] op_sel:[0,0,1] op_sel_hi:[1,0,1]
    v_cvt_pk_bf16_f32 v44, v24, v25
    v_cvt_pk_bf16_f32 v45, v26, v27
    v_cvt_pk_bf16_f32 v46, v28, v29
    v_cvt_pk_bf16_f32 v47, v30, v31
    buffer_store_dwordx4 v[44:47], v2, s[28:31], s36 offen offset:1024 sc1
L_r5:
    s_waitcnt vmcnt(6)
    v_readfirstlane_b32 s16, v48
    s_lshl_b32 s16, s16, 16
    v_dot2_f32_bf16 v16, v48, v14, s16 neg_lo:[0,0,1]
    v_dot2_f32_bf16 v17, v48, v15, s16 neg_lo:[0,0,1]
    v_dot2_f32_bf16 v18, v49, v14, s16 neg_lo:[0,0,1]
    v_dot2_f32_bf16 v19, v49, v15, s16 neg_lo:[0,0,1]
    v_dot2_f32_bf16 v20, v50, v14, s16 neg_lo:[0,0,1]
    v_dot2_f32_bf16 v21, v50, v15, s16 neg_lo:[0,0,1]
    v_dot2_f32_bf16 v22, v51, v14, s16 neg_lo:[0,0,1]
    v_dot2_f32_bf16 v23, v51, v15, s16 neg_lo:[0,0,1]
    v_pk_mul_f32 v[8:9], v[16:17], v[16:17]
    v_pk_add_f32 v[6:7], v[16:17], v[18:19]
    v_pk_fma_f32 v[8:9], v[18:19], v[18:19], v[8:9]
    v_pk_add_f32 v[6:7], v[6:7], v[20:21]
    v_pk_fma_f32 v[8:9], v[20:21], v[20:21], v[8:9]
    v_pk_add_f32 v[6:7], v[6:7], v[22:23]
    v_pk_fma_f32 v[8:9], v[22:23], v[22:23], v[8:9]
    s_waitcnt vmcnt(3)
    buffer_load_dwordx4 v[36:39], v2, s[12:15], s38 offen offset:1024 nt
    v_dot2_f32_bf16 v24, v52, v14, s16 neg_lo:[0,0,1]
    v_dot2_f32_bf16 v25, v52, v15, s16 neg_lo:[0,0,1]
    v_dot2_f32_bf16 v26, v53, v14, s16 neg_lo:[0,0,1]
    v_dot2_f32_bf16 v27, v53, v15, s16 neg_lo:[0,0,1]
    v_dot2_f32_bf16 v28, v54, v14, s16 neg_lo:[0,0,1]
    v_dot2_f32_bf16 v29, v54, v15, s16 neg_lo:[0,0,1]
    v_dot2_f32_bf16 v30, v55, v14, s16 neg_lo:[0,0,1]
    v_dot2_f32_bf16 v31, v55, v15, s16 neg_lo:[0,0,1]
    v_pk_add_f32 v[6:7], v[6:7], v[24:25]
    v_pk_fma_f32 v[8:9], v[24:25], v[24:25], v[8:9]
    v_pk_add_f32 v[6:7], v[6:7], v[26:27]
    v_pk_fma_f32 v[8:9], v[26:27], v[26:27], v[8:9]
    v_pk_add_f32 v[6:7], v[6:7], v[28:29]
    v_pk_fma_f32 v[8:9], v[28:29], v[28:29], v[8:9]
    v_pk_add_f32 v[6:7], v[6:7], v[30:31]
    v_pk_fma_f32 v[8:9], v[30:31], v[30:31], v[8:9]
    v_add_f32 v6, v6, v7
    v_add_f32 v8, v8, v9
    v_mov_b32 v10, s16
    v_add_f32_dpp v6, v6, v6 row_ror:8 row_mask:0xf bank_mask:0xf
    v_add_f32_dpp v8, v8, v8 row_ror:8 row_mask:0xf bank_mask:0xf
    s_nop 0
    v_add_f32_dpp v6, v6, v6 row_ror:4 row_mask:0xf bank_mask:0xf
    v_add_f32_dpp v8, v8, v8 row_ror:4 row_mask:0xf bank_mask:0xf
    s_nop 0
    v_add_f32_dpp v6, v6, v6 row_ror:2 row_mask:0xf bank_mask:0xf
    v_add_f32_dpp v8, v8, v8 row_ror:2 row_mask:0xf bank_mask:0xf
    s_nop 0
    v_add_f32_dpp v6, v6, v6 row_ror:1 row_mask:0xf bank_mask:0xf
    v_add_f32_dpp v8, v8, v8 row_ror:1 row_mask:0xf bank_mask:0xf
    s_nop 0
    v_add_f32_dpp v6, v6, v6 row_bcast:15 row_mask:0xa bank_mask:0xf
    v_add_f32_dpp v8, v8, v8 row_bcast:15 row_mask:0xa bank_mask:0xf
    s_nop 0
    v_add_f32_dpp v6, v6, v6 row_bcast:31 row_mask:0xc bank_mask:0xf
    v_add_f32_dpp v8, v8, v8 row_bcast:31 row_mask:0xc bank_mask:0xf
    v_readlane_b32 s42, v6, 63
    v_readlane_b32 s43, v8, 63
    s_nop 0
    v_fma_f32 v6, s42, -v4, v10
    v_add_f32 v7, s42, s42
    v_cvt_pk_bf16_f32 v6, 0, v6
    v_sub_f32 v6, v6, v10
    v_fma_f32 v7, v6, s25, -v7
    v_fma_f32 v8, v6, v7, s43
    v_cvt_pk_bf16_f32 v8, 0, v8
    v_fma_f32 v8, v8, -v4, v5
    v_cvt_pk_bf16_f32 v8, 0, v8
    v_sqrt_f32 v8, v8
    s_nop 0
    v_cvt_pk_bf16_f32 v8, 0, v8
    v_rcp_f32 v8, v8
    s_nop 0
    v_mul_f32 v12, s40, v8
    v_fma_f32 v13, -v6, v12, s41
    v_pk_fma_f32 v[16:17], v[16:17], v[12:13], v[12:13] op_sel:[0,0,1] op_sel_hi:[1,0,1]
    v_pk_fma_f32 v[18:19], v[18:19], v[12:13], v[12:13] op_sel:[0,0,1] op_sel_hi:[1,0,1]
    v_pk_fma_f32 v[20:21], v[20:21], v[12:13], v[12:13] op_sel:[0,0,1] op_sel_hi:[1,0,1]
    v_pk_fma_f32 v[22:23], v[22:23], v[12:13], v[12:13] op_sel:[0,0,1] op_sel_hi:[1,0,1]
    v_cvt_pk_bf16_f32 v48, v16, v17
    v_cvt_pk_bf16_f32 v49, v18, v19
    v_cvt_pk_bf16_f32 v50, v20, v21
    v_cvt_pk_bf16_f32 v51, v22, v23
    buffer_store_dwordx4 v[48:51], v2, s[28:31], s37 offen sc1
    v_pk_fma_f32 v[24:25], v[24:25], v[12:13], v[12:13] op_sel:[0,0,1] op_sel_hi:[1,0,1]
    v_pk_fma_f32 v[26:27], v[26:27], v[12:13], v[12:13] op_sel:[0,0,1] op_sel_hi:[1,0,1]
    v_pk_fma_f32 v[28:29], v[28:29], v[12:13], v[12:13] op_sel:[0,0,1] op_sel_hi:[1,0,1]
    v_pk_fma_f32 v[30:31], v[30:31], v[12:13], v[12:13] op_sel:[0,0,1] op_sel_hi:[1,0,1]
    v_cvt_pk_bf16_f32 v52, v24, v25
    v_cvt_pk_bf16_f32 v53, v26, v27
    v_cvt_pk_bf16_f32 v54, v28, v29
    v_cvt_pk_bf16_f32 v55, v30, v31
    buffer_store_dwordx4 v[52:55], v2, s[28:31], s37 offen offset:1024 sc1
L_r6:
    s_waitcnt vmcnt(5)
    v_readfirstlane_b32 s16, v32
    buffer_load_dwordx4 v[40:43], v2, s[12:15], s39 offen nt
    s_lshl_b32 s16, s16, 16
    v_dot2_f32_bf16 v16, v32, v14, s16 neg_lo:[0,0,1]
    v_dot2_f32_bf16 v17, v32, v15, s16 neg_lo:[0,0,1]
    v_dot2_f32_bf16 v18, v33, v14, s16 neg_lo:[0,0,1]
    v_dot2_f32_bf16 v19, v33, v15, s16 neg_lo:[0,0,1]
    v_dot2_f32_bf16 v20, v34, v14, s16 neg_lo:[0,0,1]
    v_dot2_f32_bf16 v21, v34, v15, s16 neg_lo:[0,0,1]
    v_dot2_f32_bf16 v22, v35, v14, s16 neg_lo:[0,0,1]
    v_dot2_f32_bf16 v23, v35, v15, s16 neg_lo:[0,0,1]
    v_pk_mul_f32 v[8:9], v[16:17], v[16:17]
    v_pk_add_f32 v[6:7], v[16:17], v[18:19]
    v_pk_fma_f32 v[8:9], v[18:19], v[18:19], v[8:9]
    v_pk_add_f32 v[6:7], v[6:7], v[20:21]
    v_pk_fma_f32 v[8:9], v[20:21], v[20:21], v[8:9]
    v_pk_add_f32 v[6:7], v[6:7], v[22:23]
    v_pk_fma_f32 v[8:9], v[22:23], v[22:23], v[8:9]
    s_waitcnt vmcnt(3)
    buffer_load_dwordx4 v[44:47], v2, s[12:15], s39 offen offset:1024 nt
    v_dot2_f32_bf16 v24, v36, v14, s16 neg_lo:[0,0,1]
    v_dot2_f32_bf16 v25, v36, v15, s16 neg_lo:[0,0,1]
    v_dot2_f32_bf16 v26, v37, v14, s16 neg_lo:[0,0,1]
    v_dot2_f32_bf16 v27, v37, v15, s16 neg_lo:[0,0,1]
    v_dot2_f32_bf16 v28, v38, v14, s16 neg_lo:[0,0,1]
    v_dot2_f32_bf16 v29, v38, v15, s16 neg_lo:[0,0,1]
    v_dot2_f32_bf16 v30, v39, v14, s16 neg_lo:[0,0,1]
    v_dot2_f32_bf16 v31, v39, v15, s16 neg_lo:[0,0,1]
    v_pk_add_f32 v[6:7], v[6:7], v[24:25]
    v_pk_fma_f32 v[8:9], v[24:25], v[24:25], v[8:9]
    v_pk_add_f32 v[6:7], v[6:7], v[26:27]
    v_pk_fma_f32 v[8:9], v[26:27], v[26:27], v[8:9]
    v_pk_add_f32 v[6:7], v[6:7], v[28:29]
    v_pk_fma_f32 v[8:9], v[28:29], v[28:29], v[8:9]
    v_pk_add_f32 v[6:7], v[6:7], v[30:31]
    v_pk_fma_f32 v[8:9], v[30:31], v[30:31], v[8:9]
    v_add_f32 v6, v6, v7
    v_add_f32 v8, v8, v9
    v_mov_b32 v10, s16
    v_add_f32_dpp v6, v6, v6 row_ror:8 row_mask:0xf bank_mask:0xf
    v_add_f32_dpp v8, v8, v8 row_ror:8 row_mask:0xf bank_mask:0xf
    s_nop 0
    v_add_f32_dpp v6, v6, v6 row_ror:4 row_mask:0xf bank_mask:0xf
    v_add_f32_dpp v8, v8, v8 row_ror:4 row_mask:0xf bank_mask:0xf
    s_nop 0
    v_add_f32_dpp v6, v6, v6 row_ror:2 row_mask:0xf bank_mask:0xf
    v_add_f32_dpp v8, v8, v8 row_ror:2 row_mask:0xf bank_mask:0xf
    s_nop 0
    v_add_f32_dpp v6, v6, v6 row_ror:1 row_mask:0xf bank_mask:0xf
    v_add_f32_dpp v8, v8, v8 row_ror:1 row_mask:0xf bank_mask:0xf
    s_nop 0
    v_add_f32_dpp v6, v6, v6 row_bcast:15 row_mask:0xa bank_mask:0xf
    v_add_f32_dpp v8, v8, v8 row_bcast:15 row_mask:0xa bank_mask:0xf
    s_nop 0
    v_add_f32_dpp v6, v6, v6 row_bcast:31 row_mask:0xc bank_mask:0xf
    v_add_f32_dpp v8, v8, v8 row_bcast:31 row_mask:0xc bank_mask:0xf
    v_readlane_b32 s42, v6, 63
    v_readlane_b32 s43, v8, 63
    s_nop 0
    v_fma_f32 v6, s42, -v4, v10
    v_add_f32 v7, s42, s42
    v_cvt_pk_bf16_f32 v6, 0, v6
    v_sub_f32 v6, v6, v10
    v_fma_f32 v7, v6, s25, -v7
    v_fma_f32 v8, v6, v7, s43
    v_cvt_pk_bf16_f32 v8, 0, v8
    v_fma_f32 v8, v8, -v4, v5
    v_cvt_pk_bf16_f32 v8, 0, v8
    v_sqrt_f32 v8, v8
    s_nop 0
    v_cvt_pk_bf16_f32 v8, 0, v8
    v_rcp_f32 v8, v8
    s_nop 0
    v_mul_f32 v12, s40, v8
    v_fma_f32 v13, -v6, v12, s41
    v_pk_fma_f32 v[16:17], v[16:17], v[12:13], v[12:13] op_sel:[0,0,1] op_sel_hi:[1,0,1]
    v_pk_fma_f32 v[18:19], v[18:19], v[12:13], v[12:13] op_sel:[0,0,1] op_sel_hi:[1,0,1]
    v_pk_fma_f32 v[20:21], v[20:21], v[12:13], v[12:13] op_sel:[0,0,1] op_sel_hi:[1,0,1]
    v_pk_fma_f32 v[22:23], v[22:23], v[12:13], v[12:13] op_sel:[0,0,1] op_sel_hi:[1,0,1]
    v_cvt_pk_bf16_f32 v32, v16, v17
    v_cvt_pk_bf16_f32 v33, v18, v19
    v_cvt_pk_bf16_f32 v34, v20, v21
    v_cvt_pk_bf16_f32 v35, v22, v23
    buffer_store_dwordx4 v[32:35], v2, s[28:31], s38 offen sc1
    v_pk_fma_f32 v[24:25], v[24:25], v[12:13], v[12:13] op_sel:[0,0,1] op_sel_hi:[1,0,1]
    v_pk_fma_f32 v[26:27], v[26:27], v[12:13], v[12:13] op_sel:[0,0,1] op_sel_hi:[1,0,1]
    v_pk_fma_f32 v[28:29], v[28:29], v[12:13], v[12:13] op_sel:[0,0,1] op_sel_hi:[1,0,1]
    v_pk_fma_f32 v[30:31], v[30:31], v[12:13], v[12:13] op_sel:[0,0,1] op_sel_hi:[1,0,1]
    v_cvt_pk_bf16_f32 v36, v24, v25
    v_cvt_pk_bf16_f32 v37, v26, v27
    v_cvt_pk_bf16_f32 v38, v28, v29
    v_cvt_pk_bf16_f32 v39, v30, v31
    buffer_store_dwordx4 v[36:39], v2, s[28:31], s38 offen offset:1024 sc1
L_r7:
    s_waitcnt vmcnt(3)
    v_readfirstlane_b32 s16, v40
    s_lshl_b32 s16, s16, 16
    v_dot2_f32_bf16 v16, v40, v14, s16 neg_lo:[0,0,1]
    v_dot2_f32_bf16 v17, v40, v15, s16 neg_lo:[0,0,1]
    v_dot2_f32_bf16 v18, v41, v14, s16 neg_lo:[0,0,1]
    v_dot2_f32_bf16 v19, v41, v15, s16 neg_lo:[0,0,1]
    v_dot2_f32_bf16 v20, v42, v14, s16 neg_lo:[0,0,1]
    v_dot2_f32_bf16 v21, v42, v15, s16 neg_lo:[0,0,1]
    v_dot2_f32_bf16 v22, v43, v14, s16 neg_lo:[0,0,1]
    v_dot2_f32_bf16 v23, v43, v15, s16 neg_lo:[0,0,1]
    v_pk_mul_f32 v[8:9], v[16:17], v[16:17]
    v_pk_add_f32 v[6:7], v[16:17], v[18:19]
    v_pk_fma_f32 v[8:9], v[18:19], v[18:19], v[8:9]
    v_pk_add_f32 v[6:7], v[6:7], v[20:21]
    v_pk_fma_f32 v[8:9], v[20:21], v[20:21], v[8:9]
    v_pk_add_f32 v[6:7], v[6:7], v[22:23]
    v_pk_fma_f32 v[8:9], v[22:23], v[22:23], v[8:9]
    s_waitcnt vmcnt(2)
    v_dot2_f32_bf16 v24, v44, v14, s16 neg_lo:[0,0,1]
    v_dot2_f32_bf16 v25, v44, v15, s16 neg_lo:[0,0,1]
    v_dot2_f32_bf16 v26, v45, v14, s16 neg_lo:[0,0,1]
    v_dot2_f32_bf16 v27, v45, v15, s16 neg_lo:[0,0,1]
    v_dot2_f32_bf16 v28, v46, v14, s16 neg_lo:[0,0,1]
    v_dot2_f32_bf16 v29, v46, v15, s16 neg_lo:[0,0,1]
    v_dot2_f32_bf16 v30, v47, v14, s16 neg_lo:[0,0,1]
    v_dot2_f32_bf16 v31, v47, v15, s16 neg_lo:[0,0,1]
    v_pk_add_f32 v[6:7], v[6:7], v[24:25]
    v_pk_fma_f32 v[8:9], v[24:25], v[24:25], v[8:9]
    v_pk_add_f32 v[6:7], v[6:7], v[26:27]
    v_pk_fma_f32 v[8:9], v[26:27], v[26:27], v[8:9]
    v_pk_add_f32 v[6:7], v[6:7], v[28:29]
    v_pk_fma_f32 v[8:9], v[28:29], v[28:29], v[8:9]
    v_pk_add_f32 v[6:7], v[6:7], v[30:31]
    v_pk_fma_f32 v[8:9], v[30:31], v[30:31], v[8:9]
    v_add_f32 v6, v6, v7
    v_add_f32 v8, v8, v9
    v_mov_b32 v10, s16
    v_add_f32_dpp v6, v6, v6 row_ror:8 row_mask:0xf bank_mask:0xf
    v_add_f32_dpp v8, v8, v8 row_ror:8 row_mask:0xf bank_mask:0xf
    s_nop 0
    v_add_f32_dpp v6, v6, v6 row_ror:4 row_mask:0xf bank_mask:0xf
    v_add_f32_dpp v8, v8, v8 row_ror:4 row_mask:0xf bank_mask:0xf
    s_nop 0
    v_add_f32_dpp v6, v6, v6 row_ror:2 row_mask:0xf bank_mask:0xf
    v_add_f32_dpp v8, v8, v8 row_ror:2 row_mask:0xf bank_mask:0xf
    s_nop 0
    v_add_f32_dpp v6, v6, v6 row_ror:1 row_mask:0xf bank_mask:0xf
    v_add_f32_dpp v8, v8, v8 row_ror:1 row_mask:0xf bank_mask:0xf
    s_nop 0
    v_add_f32_dpp v6, v6, v6 row_bcast:15 row_mask:0xa bank_mask:0xf
    v_add_f32_dpp v8, v8, v8 row_bcast:15 row_mask:0xa bank_mask:0xf
    s_nop 0
    v_add_f32_dpp v6, v6, v6 row_bcast:31 row_mask:0xc bank_mask:0xf
    v_add_f32_dpp v8, v8, v8 row_bcast:31 row_mask:0xc bank_mask:0xf
    v_readlane_b32 s42, v6, 63
    v_readlane_b32 s43, v8, 63
    s_nop 0
    v_fma_f32 v6, s42, -v4, v10
    v_add_f32 v7, s42, s42
    v_cvt_pk_bf16_f32 v6, 0, v6
    v_sub_f32 v6, v6, v10
    v_fma_f32 v7, v6, s25, -v7
    v_fma_f32 v8, v6, v7, s43
    v_cvt_pk_bf16_f32 v8, 0, v8
    v_fma_f32 v8, v8, -v4, v5
    v_cvt_pk_bf16_f32 v8, 0, v8
    v_sqrt_f32 v8, v8
    s_nop 0
    v_cvt_pk_bf16_f32 v8, 0, v8
    v_rcp_f32 v8, v8
    s_nop 0
    v_mul_f32 v12, s40, v8
    v_fma_f32 v13, -v6, v12, s41
    v_pk_fma_f32 v[16:17], v[16:17], v[12:13], v[12:13] op_sel:[0,0,1] op_sel_hi:[1,0,1]
    v_pk_fma_f32 v[18:19], v[18:19], v[12:13], v[12:13] op_sel:[0,0,1] op_sel_hi:[1,0,1]
    v_pk_fma_f32 v[20:21], v[20:21], v[12:13], v[12:13] op_sel:[0,0,1] op_sel_hi:[1,0,1]
    v_pk_fma_f32 v[22:23], v[22:23], v[12:13], v[12:13] op_sel:[0,0,1] op_sel_hi:[1,0,1]
    v_cvt_pk_bf16_f32 v40, v16, v17
    v_cvt_pk_bf16_f32 v41, v18, v19
    v_cvt_pk_bf16_f32 v42, v20, v21
    v_cvt_pk_bf16_f32 v43, v22, v23
    buffer_store_dwordx4 v[40:43], v2, s[28:31], s39 offen
    v_pk_fma_f32 v[24:25], v[24:25], v[12:13], v[12:13] op_sel:[0,0,1] op_sel_hi:[1,0,1]
    v_pk_fma_f32 v[26:27], v[26:27], v[12:13], v[12:13] op_sel:[0,0,1] op_sel_hi:[1,0,1]
    v_pk_fma_f32 v[28:29], v[28:29], v[12:13], v[12:13] op_sel:[0,0,1] op_sel_hi:[1,0,1]
    v_pk_fma_f32 v[30:31], v[30:31], v[12:13], v[12:13] op_sel:[0,0,1] op_sel_hi:[1,0,1]
    v_cvt_pk_bf16_f32 v44, v24, v25
    v_cvt_pk_bf16_f32 v45, v26, v27
    v_cvt_pk_bf16_f32 v46, v28, v29
    v_cvt_pk_bf16_f32 v47, v30, v31
    buffer_store_dwordx4 v[44:47], v2, s[28:31], s39 offen offset:1024
L_done:
    s_endpgm
.section .rodata,"a"
.p2align 6
.amdhsa_kernel standalone__instancenorm__sampling_kernel
  .amdhsa_next_free_vgpr 56
  .amdhsa_next_free_sgpr 48
  .amdhsa_accum_offset 56
  .amdhsa_group_segment_fixed_size 0
  .amdhsa_kernarg_size 48
  .amdhsa_user_sgpr_count 2
  .amdhsa_user_sgpr_kernarg_segment_ptr 1
  .amdhsa_system_sgpr_workgroup_id_x 1
  .amdhsa_float_denorm_mode_32 3
.end_amdhsa_kernel
```
